```python
import torch

def _softmax(x, axis=-1):
    return torch.softmax(x, dim=axis)
def _gelu(x):
    return torch.nn.functional.gelu(x, approximate="tanh")
def _silu(x):
    return torch.nn.functional.silu(x)
def _sigmoid(x):
    return torch.sigmoid(x)
def _layernorm(x, axis=-1, eps=1e-5):
    m = x.mean(dim=axis, keepdim=True)
    v = x.var(dim=axis, keepdim=True, unbiased=False)
    return (x - m) / torch.sqrt(v + eps)
def _scatter_add(tgt, idx, src, axis=0):
    return tgt.clone().index_add_(axis, idx, src)
def _segment_sum(src, seg, n):
    out = torch.zeros((n,) + src.shape[1:], dtype=src.dtype)
    return out.index_add_(0, seg, src)
def _pad(x, pw):
    flat = tuple(v for pair in reversed(pw) for v in pair)
    return torch.nn.functional.pad(x, flat)

kernel_name = 'standalone__attention_interact_autoint__recsys'

def setup_inputs():

    _w = (lambda a: (lambda t: t.to(torch.bfloat16) if t.is_floating_point() else t)(torch.as_tensor(a)))
    B, F = 4096, 26
    D = max(2, (128 // 2) * 2)
    H = 2
    Dh = D // H
    return {
        "e": _w((lambda *s: torch.randn(*s, dtype=torch.bfloat16) * 0.05)(B, F, D).to(float)),
        "wq": _w((lambda *s: torch.randn(*s, dtype=torch.bfloat16) * 1.6)(H, D, Dh).to(float)),
        "wk": _w((lambda *s: torch.randn(*s, dtype=torch.bfloat16) * 1.6)(H, D, Dh).to(float)),
        "wv": _w((lambda *s: torch.randn(*s, dtype=torch.bfloat16) * 0.05)(H, D, Dh).to(float)),
        "wres": _w((lambda *s: torch.randn(*s, dtype=torch.bfloat16) * 0.05)(D, D).to(float)),
    }

def reference(e, wq, wk, wv, wres):
    H, D, Dh = wq.shape[0], wq.shape[1], wq.shape[2]
    B, F = e.shape[0], e.shape[1]
    q = torch.einsum('bfd,hdk->bhfk', e, wq)
    k = torch.einsum('bfd,hdk->bhfk', e, wk)
    v = torch.einsum('bfd,hdk->bhfk', e, wv)
    scale = float(Dh) ** -0.5
    scores = torch.einsum('bhfk,bhgk->bhfg', q, k) * scale
    attn = _softmax(scores, axis=-1)
    attn = (lambda x, dt: x.to(dt))(attn, v.dtype)
    ctx = torch.einsum('bhfg,bhgk->bhfk', attn, v)
    ctx = (lambda x, *d: x.permute(*d))(ctx, 0, 2, 1, 3).reshape(B, F, H * Dh)
    res = torch.einsum('bfd,de->bfe', e, wres)
    out = ctx + res
    mask = (lambda x, dt: x.to(dt))(out > 0, out.dtype)
    return out * mask
```

```asm
; @launch grid=(256,1,1) block=(1024,1,1) lds=163840
.amdgcn_target "amdgcn-amd-amdhsa--gfx950"
.text
.globl standalone__attention_interact_autoint__recsys_kernel
.p2align 8
.type standalone__attention_interact_autoint__recsys_kernel,@function
standalone__attention_interact_autoint__recsys_kernel:
    s_cmp_ge_u32 s2, 256
    s_cbranch_scc1 L_done
    s_load_dwordx8 s[4:11], s[0:1], 0
    s_load_dwordx4 s[12:15], s[0:1], 32
    v_and_b32 v1, 63, v0
    v_lshrrev_b32 v2, 6, v0
    s_waitcnt lgkmcnt(0)
    s_mov_b32 s16, s4
    s_and_b32 s17, s5, 0xffff
    s_mov_b32 s18, 27262976
    s_mov_b32 s19, 0x20000
    s_mov_b32 s20, s6
    s_and_b32 s21, s7, 0xffff
    s_mov_b32 s22, 32768
    s_mov_b32 s23, 0x20000
    s_mov_b32 s24, s8
    s_and_b32 s25, s9, 0xffff
    s_mov_b32 s26, 32768
    s_mov_b32 s27, 0x20000
    s_mov_b32 s28, s10
    s_and_b32 s29, s11, 0xffff
    s_mov_b32 s30, 32768
    s_mov_b32 s31, 0x20000
    s_mov_b32 s32, s12
    s_and_b32 s33, s13, 0xffff
    s_mov_b32 s34, 32768
    s_mov_b32 s35, 0x20000
    s_mov_b32 s36, s14
    s_and_b32 s37, s15, 0xffff
    s_mov_b32 s38, 27262976
    s_mov_b32 s39, 0x20000
    s_lshl_b32 s3, s2, 4
    v_add_u32 v2, s3, v2
    s_mov_b32 s40, 6656
    v_mul_lo_u32 v2, v2, s40
    v_and_b32 v3, 31, v1
    v_lshrrev_b32 v4, 5, v1
    v_lshl_add_u32 v2, v3, 8, v2
    v_lshl_add_u32 v5, v4, 4, v2
    v_lshlrev_b32 v6, 4, v0
    buffer_load_dwordx4 v[56:59], v6, s[20:23], 0 offen offset:0
    v_add_u32 v7, 16384, v6
    buffer_load_dwordx4 v[60:63], v7, s[20:23], 0 offen
    buffer_load_dwordx4 v[64:67], v6, s[24:27], 0 offen offset:0
    v_add_u32 v7, 16384, v6
    buffer_load_dwordx4 v[68:71], v7, s[24:27], 0 offen
    buffer_load_dwordx4 v[72:75], v6, s[28:31], 0 offen offset:0
    v_add_u32 v7, 16384, v6
    buffer_load_dwordx4 v[76:79], v7, s[28:31], 0 offen
    buffer_load_dwordx4 v[80:83], v6, s[32:35], 0 offen offset:0
    v_add_u32 v7, 16384, v6
    buffer_load_dwordx4 v[84:87], v7, s[32:35], 0 offen
    v_readfirstlane_b32 s48, v0
    s_nop 3
    s_lshr_b32 s48, s48, 8
    s_cmp_ge_u32 s48, 0
    s_cbranch_scc1 L_late
    buffer_load_dwordx4 v[8:11], v5, s[16:19], 0 offen offset:0
    buffer_load_dwordx4 v[12:15], v5, s[16:19], 0 offen offset:32
    buffer_load_dwordx4 v[16:19], v5, s[16:19], 0 offen offset:64
    buffer_load_dwordx4 v[20:23], v5, s[16:19], 0 offen offset:96
    buffer_load_dwordx4 v[24:27], v5, s[16:19], 0 offen offset:128
    buffer_load_dwordx4 v[28:31], v5, s[16:19], 0 offen offset:160
    buffer_load_dwordx4 v[32:35], v5, s[16:19], 0 offen offset:192
    buffer_load_dwordx4 v[36:39], v5, s[16:19], 0 offen offset:224
    s_waitcnt vmcnt(8)
    s_branch L_j
L_late:
    s_waitcnt vmcnt(0)
L_j:
    v_mov_b32 v125, v5
    v_lshrrev_b32 v6, 3, v0
    v_and_b32 v7, 3, v6
    v_bfe_u32 v120, v0, 2, 1
    v_xor_b32 v7, v7, v120
    v_lshlrev_b32 v7, 6, v7
    v_lshl_add_u32 v7, v6, 8, v7
    v_and_b32 v120, 3, v0
    v_lshl_add_u32 v7, v120, 4, v7
    v_xor_b32 v121, 128, v7
    v_lshrrev_b32 v6, 4, v0
    v_and_b32 v122, 3, v6
    v_bfe_u32 v123, v0, 2, 2
    v_xor_b32 v122, v122, v123
    v_lshlrev_b32 v122, 6, v122
    v_lshl_add_u32 v122, v6, 8, v122
    v_and_b32 v123, 3, v0
    v_lshl_add_u32 v122, v123, 4, v122
    v_add_u32 v122, 0x18000, v122
    v_add_u32 v123, 0x10000, v7
    v_add_u32 v124, 0x10000, v121
    ds_write_b128 v7, v[56:59] offset:0
    ds_write_b128 v121, v[60:63] offset:0
    ds_write_b128 v7, v[64:67] offset:32768
    ds_write_b128 v121, v[68:71] offset:32768
    ds_write_b128 v123, v[72:75]
    ds_write_b128 v124, v[76:79]
    ds_write_b128 v122, v[80:83]
    ds_write_b128 v122, v[84:87] offset:16384
    v_bfe_u32 v6, v1, 2, 2
    v_lshl_add_u32 v7, v4, 3, v6
    v_lshlrev_b32 v7, 8, v7
    v_lshl_add_u32 v7, v6, 6, v7
    v_and_b32 v120, 3, v1
    v_bfe_u32 v121, v1, 4, 1
    v_lshl_add_u32 v6, v121, 5, v7
    v_lshl_add_u32 v6, v120, 3, v6
    v_lshl_add_u32 v7, v121, 4, v7
    v_and_b32 v122, 1, v120
    v_lshl_add_u32 v7, v122, 5, v7
    v_lshrrev_b32 v122, 1, v120
    v_lshl_add_u32 v7, v122, 3, v7
    v_add_u32 v7, 0x10000, v7
    v_cmp_lt_u32 s[42:43], 31, v1
    v_cmp_gt_u32 s[44:45], 26, v3
    v_cmp_gt_u32 s[50:51], 16, v3
    v_cmp_le_u32 s[52:53], 16, v3
    v_lshlrev_b32 v3, 8, v3
    v_sub_u32 v3, v2, v3
    v_lshrrev_b32 v120, 3, v1
    v_lshl_add_u32 v3, v120, 8, v3
    v_and_b32 v120, 7, v1
    v_lshl_add_u32 v3, v120, 4, v3
    v_readfirstlane_b32 s49, v0
    s_nop 3
    s_lshr_b32 s49, s49, 6
    s_lshl_b32 s49, s49, 11
    s_add_u32 s49, s49, 131072
    s_mov_b32 s54, 4096
    v_mov_b32 v5, 0xff800000
    s_mov_b32 s41, 0x3e38aa3b
    s_waitcnt lgkmcnt(0)
    s_barrier
    s_cmp_ge_u32 s48, 0
    s_cbranch_scc0 L_k
    buffer_load_dwordx4 v[8:11], v125, s[16:19], 0 offen offset:0
    buffer_load_dwordx4 v[12:15], v125, s[16:19], 0 offen offset:32
    buffer_load_dwordx4 v[16:19], v125, s[16:19], 0 offen offset:64
    buffer_load_dwordx4 v[20:23], v125, s[16:19], 0 offen offset:96
    buffer_load_dwordx4 v[24:27], v125, s[16:19], 0 offen offset:128
    buffer_load_dwordx4 v[28:31], v125, s[16:19], 0 offen offset:160
    buffer_load_dwordx4 v[32:35], v125, s[16:19], 0 offen offset:192
    buffer_load_dwordx4 v[36:39], v125, s[16:19], 0 offen offset:224
L_k:
    s_cmp_eq_u32 s48, 0
    s_cbranch_scc0 L_p0
    s_setprio 0
L_p0:
    s_cmp_eq_u32 s48, 1
    s_cbranch_scc0 L_p1
    s_setprio 0
L_p1:
    s_cmp_eq_u32 s48, 2
    s_cbranch_scc0 L_p2
    s_setprio 0
L_p2:
    s_waitcnt vmcnt(0)
    v_xor_b32 v126, 0, v6
    ds_read_b64_tr_b16 v[40:41], v126 offset:0
    ds_read_b64_tr_b16 v[42:43], v126 offset:1024
    ds_read_b64_tr_b16 v[44:45], v126 offset:4096
    ds_read_b64_tr_b16 v[46:47], v126 offset:5120
    ds_read_b64_tr_b16 v[48:49], v126 offset:8192
    ds_read_b64_tr_b16 v[50:51], v126 offset:9216
    ds_read_b64_tr_b16 v[52:53], v126 offset:12288
    ds_read_b64_tr_b16 v[54:55], v126 offset:13312
    s_waitcnt lgkmcnt(6)
    v_mfma_f32_32x32x16_bf16 v[56:71], v[40:43], v[8:11], 0
    ds_read_b64_tr_b16 v[40:41], v126 offset:16384
    ds_read_b64_tr_b16 v[42:43], v126 offset:17408
    s_waitcnt lgkmcnt(6)
    v_mfma_f32_32x32x16_bf16 v[56:71], v[44:47], v[12:15], v[56:71]
    ds_read_b64_tr_b16 v[44:45], v126 offset:20480
    ds_read_b64_tr_b16 v[46:47], v126 offset:21504
    s_waitcnt lgkmcnt(6)
    v_mfma_f32_32x32x16_bf16 v[56:71], v[48:51], v[16:19], v[56:71]
    ds_read_b64_tr_b16 v[48:49], v126 offset:24576
    ds_read_b64_tr_b16 v[50:51], v126 offset:25600
    s_waitcnt lgkmcnt(6)
    v_mfma_f32_32x32x16_bf16 v[56:71], v[52:55], v[20:23], v[56:71]
    ds_read_b64_tr_b16 v[52:53], v126 offset:28672
    ds_read_b64_tr_b16 v[54:55], v126 offset:29696
    s_waitcnt lgkmcnt(6)
    v_mfma_f32_32x32x16_bf16 v[56:71], v[40:43], v[24:27], v[56:71]
    v_xor_b32 v126, 64, v6
    ds_read_b64_tr_b16 v[40:41], v126 offset:0
    ds_read_b64_tr_b16 v[42:43], v126 offset:1024
    s_waitcnt lgkmcnt(6)
    v_mfma_f32_32x32x16_bf16 v[56:71], v[44:47], v[28:31], v[56:71]
    ds_read_b64_tr_b16 v[44:45], v126 offset:4096
    ds_read_b64_tr_b16 v[46:47], v126 offset:5120
    s_waitcnt lgkmcnt(6)
    v_mfma_f32_32x32x16_bf16 v[56:71], v[48:51], v[32:35], v[56:71]
    ds_read_b64_tr_b16 v[48:49], v126 offset:8192
    ds_read_b64_tr_b16 v[50:51], v126 offset:9216
    s_waitcnt lgkmcnt(6)
    v_mfma_f32_32x32x16_bf16 v[56:71], v[52:55], v[36:39], v[56:71]
    ds_read_b64_tr_b16 v[52:53], v126 offset:12288
    ds_read_b64_tr_b16 v[54:55], v126 offset:13312
    s_waitcnt lgkmcnt(6)
    v_mfma_f32_32x32x16_bf16 v[72:87], v[40:43], v[8:11], 0
    ds_read_b64_tr_b16 v[40:41], v126 offset:16384
    ds_read_b64_tr_b16 v[42:43], v126 offset:17408
    s_waitcnt lgkmcnt(6)
    v_mfma_f32_32x32x16_bf16 v[72:87], v[44:47], v[12:15], v[72:87]
    ds_read_b64_tr_b16 v[44:45], v126 offset:20480
    ds_read_b64_tr_b16 v[46:47], v126 offset:21504
    s_waitcnt lgkmcnt(6)
    v_mfma_f32_32x32x16_bf16 v[72:87], v[48:51], v[16:19], v[72:87]
    ds_read_b64_tr_b16 v[48:49], v126 offset:24576
    ds_read_b64_tr_b16 v[50:51], v126 offset:25600
    s_waitcnt lgkmcnt(6)
    v_mfma_f32_32x32x16_bf16 v[72:87], v[52:55], v[20:23], v[72:87]
    ds_read_b64_tr_b16 v[52:53], v126 offset:28672
    ds_read_b64_tr_b16 v[54:55], v126 offset:29696
    s_waitcnt lgkmcnt(6)
    v_mfma_f32_32x32x16_bf16 v[72:87], v[40:43], v[24:27], v[72:87]
    v_xor_b32 v126, 0, v6
    ds_read_b64_tr_b16 v[40:41], v126 offset:32768
    ds_read_b64_tr_b16 v[42:43], v126 offset:33792
    s_waitcnt lgkmcnt(6)
    v_mfma_f32_32x32x16_bf16 v[72:87], v[44:47], v[28:31], v[72:87]
    ds_read_b64_tr_b16 v[44:45], v126 offset:36864
    ds_read_b64_tr_b16 v[46:47], v126 offset:37888
    s_waitcnt lgkmcnt(6)
    v_mfma_f32_32x32x16_bf16 v[72:87], v[48:51], v[32:35], v[72:87]
    ds_read_b64_tr_b16 v[48:49], v126 offset:40960
    ds_read_b64_tr_b16 v[50:51], v126 offset:41984
    s_waitcnt lgkmcnt(6)
    v_mfma_f32_32x32x16_bf16 v[72:87], v[52:55], v[36:39], v[72:87]
    s_nop 7
    s_nop 4
    v_cvt_pk_bf16_f32 v88, v56, v57
    v_cvt_pk_bf16_f32 v89, v58, v59
    v_cvt_pk_bf16_f32 v90, v60, v61
    v_cvt_pk_bf16_f32 v91, v62, v63
    v_cvt_pk_bf16_f32 v92, v64, v65
    v_cvt_pk_bf16_f32 v93, v66, v67
    v_cvt_pk_bf16_f32 v94, v68, v69
    v_cvt_pk_bf16_f32 v95, v70, v71
    v_cvt_pk_bf16_f32 v96, v72, v73
    v_cvt_pk_bf16_f32 v97, v74, v75
    v_cvt_pk_bf16_f32 v98, v76, v77
    v_cvt_pk_bf16_f32 v99, v78, v79
    v_cvt_pk_bf16_f32 v100, v80, v81
    v_cvt_pk_bf16_f32 v101, v82, v83
    v_cvt_pk_bf16_f32 v102, v84, v85
    v_cvt_pk_bf16_f32 v103, v86, v87
    ds_read_b64_tr_b16 v[52:53], v126 offset:45056
    ds_read_b64_tr_b16 v[54:55], v126 offset:46080
    s_waitcnt lgkmcnt(6)
    v_mfma_f32_32x32x16_bf16 v[56:71], v[40:43], v[8:11], 0
    ds_read_b64_tr_b16 v[40:41], v126 offset:49152
    ds_read_b64_tr_b16 v[42:43], v126 offset:50176
    s_waitcnt lgkmcnt(6)
    v_mfma_f32_32x32x16_bf16 v[56:71], v[44:47], v[12:15], v[56:71]
    ds_read_b64_tr_b16 v[44:45], v126 offset:53248
    ds_read_b64_tr_b16 v[46:47], v126 offset:54272
    s_waitcnt lgkmcnt(6)
    v_mfma_f32_32x32x16_bf16 v[56:71], v[48:51], v[16:19], v[56:71]
    ds_read_b64_tr_b16 v[48:49], v126 offset:57344
    ds_read_b64_tr_b16 v[50:51], v126 offset:58368
    s_waitcnt lgkmcnt(6)
    v_mfma_f32_32x32x16_bf16 v[56:71], v[52:55], v[20:23], v[56:71]
    ds_read_b64_tr_b16 v[52:53], v126 offset:61440
    ds_read_b64_tr_b16 v[54:55], v126 offset:62464
    s_waitcnt lgkmcnt(6)
    v_mfma_f32_32x32x16_bf16 v[56:71], v[40:43], v[24:27], v[56:71]
    v_xor_b32 v126, 64, v6
    ds_read_b64_tr_b16 v[40:41], v126 offset:32768
    ds_read_b64_tr_b16 v[42:43], v126 offset:33792
    s_waitcnt lgkmcnt(6)
    v_mfma_f32_32x32x16_bf16 v[56:71], v[44:47], v[28:31], v[56:71]
    ds_read_b64_tr_b16 v[44:45], v126 offset:36864
    ds_read_b64_tr_b16 v[46:47], v126 offset:37888
    s_waitcnt lgkmcnt(6)
    v_mfma_f32_32x32x16_bf16 v[56:71], v[48:51], v[32:35], v[56:71]
    ds_read_b64_tr_b16 v[48:49], v126 offset:40960
    ds_read_b64_tr_b16 v[50:51], v126 offset:41984
    s_waitcnt lgkmcnt(6)
    v_mfma_f32_32x32x16_bf16 v[56:71], v[52:55], v[36:39], v[56:71]
    ds_read_b64_tr_b16 v[52:53], v126 offset:45056
    ds_read_b64_tr_b16 v[54:55], v126 offset:46080
    s_waitcnt lgkmcnt(6)
    v_mfma_f32_32x32x16_bf16 v[72:87], v[40:43], v[8:11], 0
    ds_read_b64_tr_b16 v[40:41], v126 offset:49152
    ds_read_b64_tr_b16 v[42:43], v126 offset:50176
    s_waitcnt lgkmcnt(6)
    v_mfma_f32_32x32x16_bf16 v[72:87], v[44:47], v[12:15], v[72:87]
    ds_read_b64_tr_b16 v[44:45], v126 offset:53248
    ds_read_b64_tr_b16 v[46:47], v126 offset:54272
    s_waitcnt lgkmcnt(6)
    v_mfma_f32_32x32x16_bf16 v[72:87], v[48:51], v[16:19], v[72:87]
    ds_read_b64_tr_b16 v[48:49], v126 offset:57344
    ds_read_b64_tr_b16 v[50:51], v126 offset:58368
    s_waitcnt lgkmcnt(6)
    v_mfma_f32_32x32x16_bf16 v[72:87], v[52:55], v[20:23], v[72:87]
    ds_read_b64_tr_b16 v[52:53], v126 offset:61440
    ds_read_b64_tr_b16 v[54:55], v126 offset:62464
    s_waitcnt lgkmcnt(6)
    v_mfma_f32_32x32x16_bf16 v[72:87], v[40:43], v[24:27], v[72:87]
    v_xor_b32 v127, 0, v7
    ds_read_b64_tr_b16 v[40:41], v127 offset:0
    ds_read_b64_tr_b16 v[42:43], v127 offset:1024
    s_waitcnt lgkmcnt(6)
    v_mfma_f32_32x32x16_bf16 v[72:87], v[44:47], v[28:31], v[72:87]
    ds_read_b64_tr_b16 v[44:45], v127 offset:4096
    ds_read_b64_tr_b16 v[46:47], v127 offset:5120
    s_waitcnt lgkmcnt(6)
    v_mfma_f32_32x32x16_bf16 v[72:87], v[48:51], v[32:35], v[72:87]
    ds_read_b64_tr_b16 v[48:49], v127 offset:8192
    ds_read_b64_tr_b16 v[50:51], v127 offset:9216
    s_waitcnt lgkmcnt(6)
    v_mfma_f32_32x32x16_bf16 v[72:87], v[52:55], v[36:39], v[72:87]
    s_nop 7
    s_nop 4
    v_cvt_pk_bf16_f32 v104, v56, v57
    v_cvt_pk_bf16_f32 v105, v58, v59
    v_cvt_pk_bf16_f32 v106, v60, v61
    v_cvt_pk_bf16_f32 v107, v62, v63
    v_cvt_pk_bf16_f32 v108, v64, v65
    v_cvt_pk_bf16_f32 v109, v66, v67
    v_cvt_pk_bf16_f32 v110, v68, v69
    v_cvt_pk_bf16_f32 v111, v70, v71
    v_cvt_pk_bf16_f32 v112, v72, v73
    v_cvt_pk_bf16_f32 v113, v74, v75
    v_cvt_pk_bf16_f32 v114, v76, v77
    v_cvt_pk_bf16_f32 v115, v78, v79
    v_cvt_pk_bf16_f32 v116, v80, v81
    v_cvt_pk_bf16_f32 v117, v82, v83
    v_cvt_pk_bf16_f32 v118, v84, v85
    v_cvt_pk_bf16_f32 v119, v86, v87
    s_nop 1
    v_mfma_f32_32x32x16_bf16 v[56:71], v[104:107], v[88:91], 0
    v_mfma_f32_32x32x16_bf16 v[56:71], v[108:111], v[92:95], v[56:71]
    v_mfma_f32_32x32x16_bf16 v[56:71], v[112:115], v[96:99], v[56:71]
    v_mfma_f32_32x32x16_bf16 v[56:71], v[116:119], v[100:103], v[56:71]
    s_nop 7
    s_nop 4
    v_cndmask_b32 v68, v68, v5, s[42:43]
    v_cndmask_b32 v69, v69, v5, s[42:43]
    v_max3_f32 v120, v56, v57, v58
    v_max3_f32 v120, v120, v59, v60
    v_max3_f32 v120, v120, v61, v62
    v_max3_f32 v120, v120, v63, v64
    v_max3_f32 v120, v120, v65, v66
    v_max3_f32 v120, v120, v67, v68
    v_max_f32 v120, v120, v69
    v_mov_b32 v121, v120
    s_nop 1
    v_permlane32_swap_b32 v120, v121
    s_nop 1
    v_max_f32 v120, v120, v121
    v_mul_f32 v120, s41, v120
    v_fma_f32 v56, v56, s41, -v120
    v_fma_f32 v57, v57, s41, -v120
    v_fma_f32 v58, v58, s41, -v120
    v_fma_f32 v59, v59, s41, -v120
    v_fma_f32 v60, v60, s41, -v120
    v_fma_f32 v61, v61, s41, -v120
    v_fma_f32 v62, v62, s41, -v120
    v_fma_f32 v63, v63, s41, -v120
    v_fma_f32 v64, v64, s41, -v120
    v_fma_f32 v65, v65, s41, -v120
    v_fma_f32 v66, v66, s41, -v120
    v_fma_f32 v67, v67, s41, -v120
    v_fma_f32 v68, v68, s41, -v120
    v_fma_f32 v69, v69, s41, -v120
    v_exp_f32 v56, v56
    v_exp_f32 v57, v57
    v_exp_f32 v58, v58
    v_exp_f32 v59, v59
    v_exp_f32 v60, v60
    v_exp_f32 v61, v61
    v_exp_f32 v62, v62
    v_exp_f32 v63, v63
    v_exp_f32 v64, v64
    v_exp_f32 v65, v65
    v_exp_f32 v66, v66
    v_exp_f32 v67, v67
    v_exp_f32 v68, v68
    v_exp_f32 v69, v69
    v_add_f32 v120, v56, v57
    v_add_f32 v120, v120, v58
    v_add_f32 v120, v120, v59
    v_add_f32 v120, v120, v60
    v_add_f32 v120, v120, v61
    v_add_f32 v120, v120, v62
    v_add_f32 v120, v120, v63
    v_add_f32 v120, v120, v64
    v_add_f32 v120, v120, v65
    v_add_f32 v120, v120, v66
    v_add_f32 v120, v120, v67
    v_add_f32 v120, v120, v68
    v_add_f32 v120, v120, v69
    v_mov_b32 v121, v120
    s_nop 1
    v_permlane32_swap_b32 v120, v121
    s_nop 1
    v_add_f32 v120, v120, v121
    v_rcp_f32 v120, v120
    s_nop 0
    v_mul_f32 v56, v56, v120
    v_mul_f32 v57, v57, v120
    v_mul_f32 v58, v58, v120
    v_mul_f32 v59, v59, v120
    v_mul_f32 v60, v60, v120
    v_mul_f32 v61, v61, v120
    v_mul_f32 v62, v62, v120
    v_mul_f32 v63, v63, v120
    v_mul_f32 v64, v64, v120
    v_mul_f32 v65, v65, v120
    v_mul_f32 v66, v66, v120
    v_mul_f32 v67, v67, v120
    v_mul_f32 v68, v68, v120
    v_mul_f32 v69, v69, v120
    v_cvt_pk_bf16_f32 v88, v56, v57
    v_cvt_pk_bf16_f32 v89, v58, v59
    v_cvt_pk_bf16_f32 v90, v60, v61
    v_cvt_pk_bf16_f32 v91, v62, v63
    v_cvt_pk_bf16_f32 v92, v64, v65
    v_cvt_pk_bf16_f32 v93, v66, v67
    v_cvt_pk_bf16_f32 v94, v68, v69
    v_mov_b32 v95, 0
    ds_read_b64_tr_b16 v[52:53], v127 offset:12288
    ds_read_b64_tr_b16 v[54:55], v127 offset:13312
    s_waitcnt lgkmcnt(6)
    v_mfma_f32_32x32x16_bf16 v[56:71], v[8:11], v[40:43], 0
    ds_read_b64_tr_b16 v[40:41], v127 offset:16384
    ds_read_b64_tr_b16 v[42:43], v127 offset:17408
    s_waitcnt lgkmcnt(6)
    v_mfma_f32_32x32x16_bf16 v[56:71], v[12:15], v[44:47], v[56:71]
    ds_read_b64_tr_b16 v[44:45], v127 offset:20480
    ds_read_b64_tr_b16 v[46:47], v127 offset:21504
    s_waitcnt lgkmcnt(6)
    v_mfma_f32_32x32x16_bf16 v[56:71], v[16:19], v[48:51], v[56:71]
    ds_read_b64_tr_b16 v[48:49], v127 offset:24576
    ds_read_b64_tr_b16 v[50:51], v127 offset:25600
    s_waitcnt lgkmcnt(6)
    v_mfma_f32_32x32x16_bf16 v[56:71], v[20:23], v[52:55], v[56:71]
    ds_read_b64_tr_b16 v[52:53], v127 offset:28672
    ds_read_b64_tr_b16 v[54:55], v127 offset:29696
    s_waitcnt lgkmcnt(6)
    v_mfma_f32_32x32x16_bf16 v[56:71], v[24:27], v[40:43], v[56:71]
    v_xor_b32 v127, 64, v7
    ds_read_b64_tr_b16 v[40:41], v127 offset:0
    ds_read_b64_tr_b16 v[42:43], v127 offset:1024
    s_waitcnt lgkmcnt(6)
    v_mfma_f32_32x32x16_bf16 v[56:71], v[28:31], v[44:47], v[56:71]
    ds_read_b64_tr_b16 v[44:45], v127 offset:4096
    ds_read_b64_tr_b16 v[46:47], v127 offset:5120
    s_waitcnt lgkmcnt(6)
    v_mfma_f32_32x32x16_bf16 v[56:71], v[32:35], v[48:51], v[56:71]
    ds_read_b64_tr_b16 v[48:49], v127 offset:8192
    ds_read_b64_tr_b16 v[50:51], v127 offset:9216
    s_waitcnt lgkmcnt(6)
    v_mfma_f32_32x32x16_bf16 v[56:71], v[36:39], v[52:55], v[56:71]
    ds_read_b64_tr_b16 v[52:53], v127 offset:12288
    ds_read_b64_tr_b16 v[54:55], v127 offset:13312
    s_waitcnt lgkmcnt(6)
    v_mfma_f32_32x32x16_bf16 v[72:87], v[8:11], v[40:43], 0
    ds_read_b64_tr_b16 v[40:41], v127 offset:16384
    ds_read_b64_tr_b16 v[42:43], v127 offset:17408
    s_waitcnt lgkmcnt(6)
    v_mfma_f32_32x32x16_bf16 v[72:87], v[12:15], v[44:47], v[72:87]
    ds_read_b64_tr_b16 v[44:45], v127 offset:20480
    ds_read_b64_tr_b16 v[46:47], v127 offset:21504
    s_waitcnt lgkmcnt(6)
    v_mfma_f32_32x32x16_bf16 v[72:87], v[16:19], v[48:51], v[72:87]
    ds_read_b64_tr_b16 v[48:49], v127 offset:24576
    ds_read_b64_tr_b16 v[50:51], v127 offset:25600
    s_waitcnt lgkmcnt(6)
    v_mfma_f32_32x32x16_bf16 v[72:87], v[20:23], v[52:55], v[72:87]
    ds_read_b64_tr_b16 v[52:53], v127 offset:28672
    ds_read_b64_tr_b16 v[54:55], v127 offset:29696
    s_waitcnt lgkmcnt(6)
    v_mfma_f32_32x32x16_bf16 v[72:87], v[24:27], v[40:43], v[72:87]
    v_xor_b32 v127, 0, v7
    ds_read_b64_tr_b16 v[40:41], v127 offset:32768
    ds_read_b64_tr_b16 v[42:43], v127 offset:33792
    s_waitcnt lgkmcnt(6)
    v_mfma_f32_32x32x16_bf16 v[72:87], v[28:31], v[44:47], v[72:87]
    ds_read_b64_tr_b16 v[44:45], v127 offset:36864
    ds_read_b64_tr_b16 v[46:47], v127 offset:37888
    s_waitcnt lgkmcnt(6)
    v_mfma_f32_32x32x16_bf16 v[72:87], v[32:35], v[48:51], v[72:87]
    ds_read_b64_tr_b16 v[48:49], v127 offset:40960
    ds_read_b64_tr_b16 v[50:51], v127 offset:41984
    s_waitcnt lgkmcnt(6)
    v_mfma_f32_32x32x16_bf16 v[72:87], v[36:39], v[52:55], v[72:87]
    s_nop 7
    s_nop 4
    v_cvt_pk_bf16_f32 v104, v56, v57
    v_cvt_pk_bf16_f32 v105, v58, v59
    v_cvt_pk_bf16_f32 v106, v60, v61
    v_cvt_pk_bf16_f32 v107, v62, v63
    v_cvt_pk_bf16_f32 v108, v64, v65
    v_cvt_pk_bf16_f32 v109, v66, v67
    v_cvt_pk_bf16_f32 v110, v68, v69
    v_cvt_pk_bf16_f32 v111, v70, v71
    v_cvt_pk_bf16_f32 v112, v72, v73
    v_cvt_pk_bf16_f32 v113, v74, v75
    v_cvt_pk_bf16_f32 v114, v76, v77
    v_cvt_pk_bf16_f32 v115, v78, v79
    v_cvt_pk_bf16_f32 v116, v80, v81
    v_cvt_pk_bf16_f32 v117, v82, v83
    v_cvt_pk_bf16_f32 v118, v84, v85
    v_cvt_pk_bf16_f32 v119, v86, v87
    ds_read_b64_tr_b16 v[52:53], v127 offset:45056
    ds_read_b64_tr_b16 v[54:55], v127 offset:46080
    s_waitcnt lgkmcnt(6)
    v_mfma_f32_32x32x16_bf16 v[56:71], v[40:43], v[8:11], 0
    ds_read_b64_tr_b16 v[40:41], v127 offset:49152
    ds_read_b64_tr_b16 v[42:43], v127 offset:50176
    s_waitcnt lgkmcnt(6)
    v_mfma_f32_32x32x16_bf16 v[56:71], v[44:47], v[12:15], v[56:71]
    ds_read_b64_tr_b16 v[44:45], v127 offset:53248
    ds_read_b64_tr_b16 v[46:47], v127 offset:54272
    s_waitcnt lgkmcnt(6)
    v_mfma_f32_32x32x16_bf16 v[56:71], v[48:51], v[16:19], v[56:71]
    ds_read_b64_tr_b16 v[48:49], v127 offset:57344
    ds_read_b64_tr_b16 v[50:51], v127 offset:58368
    s_waitcnt lgkmcnt(6)
    v_mfma_f32_32x32x16_bf16 v[56:71], v[52:55], v[20:23], v[56:71]
    ds_read_b64_tr_b16 v[52:53], v127 offset:61440
    ds_read_b64_tr_b16 v[54:55], v127 offset:62464
    s_waitcnt lgkmcnt(6)
    v_mfma_f32_32x32x16_bf16 v[56:71], v[40:43], v[24:27], v[56:71]
    v_xor_b32 v127, 64, v7
    ds_read_b64_tr_b16 v[40:41], v127 offset:32768
    ds_read_b64_tr_b16 v[42:43], v127 offset:33792
    s_waitcnt lgkmcnt(6)
    v_mfma_f32_32x32x16_bf16 v[56:71], v[44:47], v[28:31], v[56:71]
    ds_read_b64_tr_b16 v[44:45], v127 offset:36864
    ds_read_b64_tr_b16 v[46:47], v127 offset:37888
    s_waitcnt lgkmcnt(6)
    v_mfma_f32_32x32x16_bf16 v[56:71], v[48:51], v[32:35], v[56:71]
    ds_read_b64_tr_b16 v[48:49], v127 offset:40960
    ds_read_b64_tr_b16 v[50:51], v127 offset:41984
    s_waitcnt lgkmcnt(6)
    v_mfma_f32_32x32x16_bf16 v[56:71], v[52:55], v[36:39], v[56:71]
    ds_read_b64_tr_b16 v[52:53], v127 offset:45056
    ds_read_b64_tr_b16 v[54:55], v127 offset:46080
    s_waitcnt lgkmcnt(6)
    v_mfma_f32_32x32x16_bf16 v[72:87], v[40:43], v[8:11], 0
    ds_read_b64_tr_b16 v[40:41], v127 offset:49152
    ds_read_b64_tr_b16 v[42:43], v127 offset:50176
    s_waitcnt lgkmcnt(6)
    v_mfma_f32_32x32x16_bf16 v[72:87], v[44:47], v[12:15], v[72:87]
    ds_read_b64_tr_b16 v[44:45], v127 offset:53248
    ds_read_b64_tr_b16 v[46:47], v127 offset:54272
    s_waitcnt lgkmcnt(6)
    v_mfma_f32_32x32x16_bf16 v[72:87], v[48:51], v[16:19], v[72:87]
    ds_read_b64_tr_b16 v[48:49], v127 offset:57344
    ds_read_b64_tr_b16 v[50:51], v127 offset:58368
    s_waitcnt lgkmcnt(6)
    v_mfma_f32_32x32x16_bf16 v[72:87], v[52:55], v[20:23], v[72:87]
    ds_read_b64_tr_b16 v[52:53], v127 offset:61440
    ds_read_b64_tr_b16 v[54:55], v127 offset:62464
    s_waitcnt lgkmcnt(6)
    v_mfma_f32_32x32x16_bf16 v[72:87], v[40:43], v[24:27], v[72:87]
    v_xor_b32 v126, 128, v6
    ds_read_b64_tr_b16 v[40:41], v126 offset:0
    ds_read_b64_tr_b16 v[42:43], v126 offset:1024
    s_waitcnt lgkmcnt(6)
    v_mfma_f32_32x32x16_bf16 v[72:87], v[44:47], v[28:31], v[72:87]
    ds_read_b64_tr_b16 v[44:45], v126 offset:4096
    ds_read_b64_tr_b16 v[46:47], v126 offset:5120
    s_waitcnt lgkmcnt(6)
    v_mfma_f32_32x32x16_bf16 v[72:87], v[48:51], v[32:35], v[72:87]
    ds_read_b64_tr_b16 v[48:49], v126 offset:8192
    ds_read_b64_tr_b16 v[50:51], v126 offset:9216
    s_waitcnt lgkmcnt(6)
    v_mfma_f32_32x32x16_bf16 v[72:87], v[52:55], v[36:39], v[72:87]
    s_nop 1
    v_mfma_f32_32x32x16_bf16 v[56:71], v[104:107], v[88:91], v[56:71]
    v_mfma_f32_32x32x16_bf16 v[56:71], v[108:111], v[92:95], v[56:71]
    v_mfma_f32_32x32x16_bf16 v[72:87], v[112:115], v[88:91], v[72:87]
    v_mfma_f32_32x32x16_bf16 v[72:87], v[116:119], v[92:95], v[72:87]
    s_nop 7
    s_nop 4
    v_max_f32 v56, 0, v56
    v_max_f32 v57, 0, v57
    v_max_f32 v58, 0, v58
    v_max_f32 v59, 0, v59
    v_max_f32 v60, 0, v60
    v_max_f32 v61, 0, v61
    v_max_f32 v62, 0, v62
    v_max_f32 v63, 0, v63
    v_max_f32 v64, 0, v64
    v_max_f32 v65, 0, v65
    v_max_f32 v66, 0, v66
    v_max_f32 v67, 0, v67
    v_max_f32 v68, 0, v68
    v_max_f32 v69, 0, v69
    v_max_f32 v70, 0, v70
    v_max_f32 v71, 0, v71
    v_cvt_pk_bf16_f32 v104, v56, v57
    v_cvt_pk_bf16_f32 v105, v58, v59
    v_cvt_pk_bf16_f32 v106, v60, v61
    v_cvt_pk_bf16_f32 v107, v62, v63
    v_cvt_pk_bf16_f32 v108, v64, v65
    v_cvt_pk_bf16_f32 v109, v66, v67
    v_cvt_pk_bf16_f32 v110, v68, v69
    v_cvt_pk_bf16_f32 v111, v70, v71
    v_max_f32 v72, 0, v72
    v_max_f32 v73, 0, v73
    v_max_f32 v74, 0, v74
    v_max_f32 v75, 0, v75
    v_max_f32 v76, 0, v76
    v_max_f32 v77, 0, v77
    v_max_f32 v78, 0, v78
    v_max_f32 v79, 0, v79
    v_max_f32 v80, 0, v80
    v_max_f32 v81, 0, v81
    v_max_f32 v82, 0, v82
    v_max_f32 v83, 0, v83
    v_max_f32 v84, 0, v84
    v_max_f32 v85, 0, v85
    v_max_f32 v86, 0, v86
    v_max_f32 v87, 0, v87
    v_cvt_pk_bf16_f32 v112, v72, v73
    v_cvt_pk_bf16_f32 v113, v74, v75
    v_cvt_pk_bf16_f32 v114, v76, v77
    v_cvt_pk_bf16_f32 v115, v78, v79
    v_cvt_pk_bf16_f32 v116, v80, v81
    v_cvt_pk_bf16_f32 v117, v82, v83
    v_cvt_pk_bf16_f32 v118, v84, v85
    v_cvt_pk_bf16_f32 v119, v86, v87
    v_and_b32 v122, 7, v1
    v_lshlrev_b32 v123, 1, v4
    v_xor_b32 v122, v122, v123
    v_and_b32 v123, 15, v1
    v_lshlrev_b32 v123, 7, v123
    v_lshl_add_u32 v120, v122, 4, v123
    v_add_u32 v120, s49, v120
    v_lshrrev_b32 v122, 3, v1
    v_and_b32 v123, 7, v1
    v_xor_b32 v123, v123, v122
    v_lshlrev_b32 v123, 4, v123
    v_lshl_add_u32 v121, v122, 7, v123
    v_add_u32 v121, s49, v121
    v_xor_b32 v122, 0, v120
    v_xor_b32 v123, 16, v120
    v_xor_b32 v124, 64, v120
    v_xor_b32 v125, 80, v120
    s_mov_b64 exec, s[50:51]
    ds_write_b128 v122, v[104:107]
    ds_write_b128 v123, v[108:111]
    ds_write_b128 v124, v[112:115]
    ds_write_b128 v125, v[116:119]
    s_mov_b64 exec, -1
    s_waitcnt lgkmcnt(0)
    ds_read_b128 v[56:59], v121
    ds_read_b128 v[60:63], v121 offset:1024
    s_waitcnt lgkmcnt(0)
    buffer_store_dwordx4 v[56:59], v3, s[36:39], 0 offen offset:0 nt
    buffer_store_dwordx4 v[60:63], v3, s[36:39], 0 offen offset:2048 nt
    s_mov_b64 exec, s[52:53]
    ds_write_b128 v122, v[104:107]
    ds_write_b128 v123, v[108:111]
    ds_write_b128 v124, v[112:115]
    ds_write_b128 v125, v[116:119]
    s_mov_b64 exec, -1
    s_waitcnt lgkmcnt(0)
    ds_read_b128 v[64:67], v121
    ds_read_b128 v[68:71], v121 offset:1024
    s_waitcnt lgkmcnt(0)
    buffer_store_dwordx4 v[64:67], v3, s[36:39], s54 offen offset:0 nt
    s_mov_b64 exec, 0xffff
    buffer_store_dwordx4 v[68:71], v3, s[36:39], s54 offen offset:2048 nt
    s_mov_b64 exec, -1
    ds_read_b64_tr_b16 v[52:53], v126 offset:12288
    ds_read_b64_tr_b16 v[54:55], v126 offset:13312
    s_waitcnt lgkmcnt(6)
    v_mfma_f32_32x32x16_bf16 v[56:71], v[40:43], v[8:11], 0
    ds_read_b64_tr_b16 v[40:41], v126 offset:16384
    ds_read_b64_tr_b16 v[42:43], v126 offset:17408
    s_waitcnt lgkmcnt(6)
    v_mfma_f32_32x32x16_bf16 v[56:71], v[44:47], v[12:15], v[56:71]
    ds_read_b64_tr_b16 v[44:45], v126 offset:20480
    ds_read_b64_tr_b16 v[46:47], v126 offset:21504
    s_waitcnt lgkmcnt(6)
    v_mfma_f32_32x32x16_bf16 v[56:71], v[48:51], v[16:19], v[56:71]
    ds_read_b64_tr_b16 v[48:49], v126 offset:24576
    ds_read_b64_tr_b16 v[50:51], v126 offset:25600
    s_waitcnt lgkmcnt(6)
    v_mfma_f32_32x32x16_bf16 v[56:71], v[52:55], v[20:23], v[56:71]
    ds_read_b64_tr_b16 v[52:53], v126 offset:28672
    ds_read_b64_tr_b16 v[54:55], v126 offset:29696
    s_waitcnt lgkmcnt(6)
    v_mfma_f32_32x32x16_bf16 v[56:71], v[40:43], v[24:27], v[56:71]
    v_xor_b32 v126, 192, v6
    ds_read_b64_tr_b16 v[40:41], v126 offset:0
    ds_read_b64_tr_b16 v[42:43], v126 offset:1024
    s_waitcnt lgkmcnt(6)
    v_mfma_f32_32x32x16_bf16 v[56:71], v[44:47], v[28:31], v[56:71]
    ds_read_b64_tr_b16 v[44:45], v126 offset:4096
    ds_read_b64_tr_b16 v[46:47], v126 offset:5120
    s_waitcnt lgkmcnt(6)
    v_mfma_f32_32x32x16_bf16 v[56:71], v[48:51], v[32:35], v[56:71]
    ds_read_b64_tr_b16 v[48:49], v126 offset:8192
    ds_read_b64_tr_b16 v[50:51], v126 offset:9216
    s_waitcnt lgkmcnt(6)
    v_mfma_f32_32x32x16_bf16 v[56:71], v[52:55], v[36:39], v[56:71]
    ds_read_b64_tr_b16 v[52:53], v126 offset:12288
    ds_read_b64_tr_b16 v[54:55], v126 offset:13312
    s_waitcnt lgkmcnt(6)
    v_mfma_f32_32x32x16_bf16 v[72:87], v[40:43], v[8:11], 0
    ds_read_b64_tr_b16 v[40:41], v126 offset:16384
    ds_read_b64_tr_b16 v[42:43], v126 offset:17408
    s_waitcnt lgkmcnt(6)
    v_mfma_f32_32x32x16_bf16 v[72:87], v[44:47], v[12:15], v[72:87]
    ds_read_b64_tr_b16 v[44:45], v126 offset:20480
    ds_read_b64_tr_b16 v[46:47], v126 offset:21504
    s_waitcnt lgkmcnt(6)
    v_mfma_f32_32x32x16_bf16 v[72:87], v[48:51], v[16:19], v[72:87]
    ds_read_b64_tr_b16 v[48:49], v126 offset:24576
    ds_read_b64_tr_b16 v[50:51], v126 offset:25600
    s_waitcnt lgkmcnt(6)
    v_mfma_f32_32x32x16_bf16 v[72:87], v[52:55], v[20:23], v[72:87]
    ds_read_b64_tr_b16 v[52:53], v126 offset:28672
    ds_read_b64_tr_b16 v[54:55], v126 offset:29696
    s_waitcnt lgkmcnt(6)
    v_mfma_f32_32x32x16_bf16 v[72:87], v[40:43], v[24:27], v[72:87]
    v_xor_b32 v126, 128, v6
    ds_read_b64_tr_b16 v[40:41], v126 offset:32768
    ds_read_b64_tr_b16 v[42:43], v126 offset:33792
    s_waitcnt lgkmcnt(6)
    v_mfma_f32_32x32x16_bf16 v[72:87], v[44:47], v[28:31], v[72:87]
    ds_read_b64_tr_b16 v[44:45], v126 offset:36864
    ds_read_b64_tr_b16 v[46:47], v126 offset:37888
    s_waitcnt lgkmcnt(6)
    v_mfma_f32_32x32x16_bf16 v[72:87], v[48:51], v[32:35], v[72:87]
    ds_read_b64_tr_b16 v[48:49], v126 offset:40960
    ds_read_b64_tr_b16 v[50:51], v126 offset:41984
    s_waitcnt lgkmcnt(6)
    v_mfma_f32_32x32x16_bf16 v[72:87], v[52:55], v[36:39], v[72:87]
    s_nop 7
    s_nop 4
    v_cvt_pk_bf16_f32 v88, v56, v57
    v_cvt_pk_bf16_f32 v89, v58, v59
    v_cvt_pk_bf16_f32 v90, v60, v61
    v_cvt_pk_bf16_f32 v91, v62, v63
    v_cvt_pk_bf16_f32 v92, v64, v65
    v_cvt_pk_bf16_f32 v93, v66, v67
    v_cvt_pk_bf16_f32 v94, v68, v69
    v_cvt_pk_bf16_f32 v95, v70, v71
    v_cvt_pk_bf16_f32 v96, v72, v73
    v_cvt_pk_bf16_f32 v97, v74, v75
    v_cvt_pk_bf16_f32 v98, v76, v77
    v_cvt_pk_bf16_f32 v99, v78, v79
    v_cvt_pk_bf16_f32 v100, v80, v81
    v_cvt_pk_bf16_f32 v101, v82, v83
    v_cvt_pk_bf16_f32 v102, v84, v85
    v_cvt_pk_bf16_f32 v103, v86, v87
    ds_read_b64_tr_b16 v[52:53], v126 offset:45056
    ds_read_b64_tr_b16 v[54:55], v126 offset:46080
    s_waitcnt lgkmcnt(6)
    v_mfma_f32_32x32x16_bf16 v[56:71], v[40:43], v[8:11], 0
    ds_read_b64_tr_b16 v[40:41], v126 offset:49152
    ds_read_b64_tr_b16 v[42:43], v126 offset:50176
    s_waitcnt lgkmcnt(6)
    v_mfma_f32_32x32x16_bf16 v[56:71], v[44:47], v[12:15], v[56:71]
    ds_read_b64_tr_b16 v[44:45], v126 offset:53248
    ds_read_b64_tr_b16 v[46:47], v126 offset:54272
    s_waitcnt lgkmcnt(6)
    v_mfma_f32_32x32x16_bf16 v[56:71], v[48:51], v[16:19], v[56:71]
    ds_read_b64_tr_b16 v[48:49], v126 offset:57344
    ds_read_b64_tr_b16 v[50:51], v126 offset:58368
    s_waitcnt lgkmcnt(6)
    v_mfma_f32_32x32x16_bf16 v[56:71], v[52:55], v[20:23], v[56:71]
    ds_read_b64_tr_b16 v[52:53], v126 offset:61440
    ds_read_b64_tr_b16 v[54:55], v126 offset:62464
    s_waitcnt lgkmcnt(6)
    v_mfma_f32_32x32x16_bf16 v[56:71], v[40:43], v[24:27], v[56:71]
    v_xor_b32 v126, 192, v6
    ds_read_b64_tr_b16 v[40:41], v126 offset:32768
    ds_read_b64_tr_b16 v[42:43], v126 offset:33792
    s_waitcnt lgkmcnt(6)
    v_mfma_f32_32x32x16_bf16 v[56:71], v[44:47], v[28:31], v[56:71]
    ds_read_b64_tr_b16 v[44:45], v126 offset:36864
    ds_read_b64_tr_b16 v[46:47], v126 offset:37888
    s_waitcnt lgkmcnt(6)
    v_mfma_f32_32x32x16_bf16 v[56:71], v[48:51], v[32:35], v[56:71]
    ds_read_b64_tr_b16 v[48:49], v126 offset:40960
    ds_read_b64_tr_b16 v[50:51], v126 offset:41984
    s_waitcnt lgkmcnt(6)
    v_mfma_f32_32x32x16_bf16 v[56:71], v[52:55], v[36:39], v[56:71]
    ds_read_b64_tr_b16 v[52:53], v126 offset:45056
    ds_read_b64_tr_b16 v[54:55], v126 offset:46080
    s_waitcnt lgkmcnt(6)
    v_mfma_f32_32x32x16_bf16 v[72:87], v[40:43], v[8:11], 0
    ds_read_b64_tr_b16 v[40:41], v126 offset:49152
    ds_read_b64_tr_b16 v[42:43], v126 offset:50176
    s_waitcnt lgkmcnt(6)
    v_mfma_f32_32x32x16_bf16 v[72:87], v[44:47], v[12:15], v[72:87]
    ds_read_b64_tr_b16 v[44:45], v126 offset:53248
    ds_read_b64_tr_b16 v[46:47], v126 offset:54272
    s_waitcnt lgkmcnt(6)
    v_mfma_f32_32x32x16_bf16 v[72:87], v[48:51], v[16:19], v[72:87]
    ds_read_b64_tr_b16 v[48:49], v126 offset:57344
    ds_read_b64_tr_b16 v[50:51], v126 offset:58368
    s_waitcnt lgkmcnt(6)
    v_mfma_f32_32x32x16_bf16 v[72:87], v[52:55], v[20:23], v[72:87]
    ds_read_b64_tr_b16 v[52:53], v126 offset:61440
    ds_read_b64_tr_b16 v[54:55], v126 offset:62464
    s_waitcnt lgkmcnt(6)
    v_mfma_f32_32x32x16_bf16 v[72:87], v[40:43], v[24:27], v[72:87]
    v_xor_b32 v127, 128, v7
    ds_read_b64_tr_b16 v[40:41], v127 offset:0
    ds_read_b64_tr_b16 v[42:43], v127 offset:1024
    s_waitcnt lgkmcnt(6)
    v_mfma_f32_32x32x16_bf16 v[72:87], v[44:47], v[28:31], v[72:87]
    ds_read_b64_tr_b16 v[44:45], v127 offset:4096
    ds_read_b64_tr_b16 v[46:47], v127 offset:5120
    s_waitcnt lgkmcnt(6)
    v_mfma_f32_32x32x16_bf16 v[72:87], v[48:51], v[32:35], v[72:87]
    ds_read_b64_tr_b16 v[48:49], v127 offset:8192
    ds_read_b64_tr_b16 v[50:51], v127 offset:9216
    s_waitcnt lgkmcnt(6)
    v_mfma_f32_32x32x16_bf16 v[72:87], v[52:55], v[36:39], v[72:87]
    s_nop 7
    s_nop 4
    v_cvt_pk_bf16_f32 v104, v56, v57
    v_cvt_pk_bf16_f32 v105, v58, v59
    v_cvt_pk_bf16_f32 v106, v60, v61
    v_cvt_pk_bf16_f32 v107, v62, v63
    v_cvt_pk_bf16_f32 v108, v64, v65
    v_cvt_pk_bf16_f32 v109, v66, v67
    v_cvt_pk_bf16_f32 v110, v68, v69
    v_cvt_pk_bf16_f32 v111, v70, v71
    v_cvt_pk_bf16_f32 v112, v72, v73
    v_cvt_pk_bf16_f32 v113, v74, v75
    v_cvt_pk_bf16_f32 v114, v76, v77
    v_cvt_pk_bf16_f32 v115, v78, v79
    v_cvt_pk_bf16_f32 v116, v80, v81
    v_cvt_pk_bf16_f32 v117, v82, v83
    v_cvt_pk_bf16_f32 v118, v84, v85
    v_cvt_pk_bf16_f32 v119, v86, v87
    s_nop 1
    v_mfma_f32_32x32x16_bf16 v[56:71], v[104:107], v[88:91], 0
    v_mfma_f32_32x32x16_bf16 v[56:71], v[108:111], v[92:95], v[56:71]
    v_mfma_f32_32x32x16_bf16 v[56:71], v[112:115], v[96:99], v[56:71]
    v_mfma_f32_32x32x16_bf16 v[56:71], v[116:119], v[100:103], v[56:71]
    s_nop 7
    s_nop 4
    v_cndmask_b32 v68, v68, v5, s[42:43]
    v_cndmask_b32 v69, v69, v5, s[42:43]
    v_max3_f32 v120, v56, v57, v58
    v_max3_f32 v120, v120, v59, v60
    v_max3_f32 v120, v120, v61, v62
    v_max3_f32 v120, v120, v63, v64
    v_max3_f32 v120, v120, v65, v66
    v_max3_f32 v120, v120, v67, v68
    v_max_f32 v120, v120, v69
    v_mov_b32 v121, v120
    s_nop 1
    v_permlane32_swap_b32 v120, v121
    s_nop 1
    v_max_f32 v120, v120, v121
    v_mul_f32 v120, s41, v120
    v_fma_f32 v56, v56, s41, -v120
    v_fma_f32 v57, v57, s41, -v120
    v_fma_f32 v58, v58, s41, -v120
    v_fma_f32 v59, v59, s41, -v120
    v_fma_f32 v60, v60, s41, -v120
    v_fma_f32 v61, v61, s41, -v120
    v_fma_f32 v62, v62, s41, -v120
    v_fma_f32 v63, v63, s41, -v120
    v_fma_f32 v64, v64, s41, -v120
    v_fma_f32 v65, v65, s41, -v120
    v_fma_f32 v66, v66, s41, -v120
    v_fma_f32 v67, v67, s41, -v120
    v_fma_f32 v68, v68, s41, -v120
    v_fma_f32 v69, v69, s41, -v120
    v_exp_f32 v56, v56
    v_exp_f32 v57, v57
    v_exp_f32 v58, v58
    v_exp_f32 v59, v59
    v_exp_f32 v60, v60
    v_exp_f32 v61, v61
    v_exp_f32 v62, v62
    v_exp_f32 v63, v63
    v_exp_f32 v64, v64
    v_exp_f32 v65, v65
    v_exp_f32 v66, v66
    v_exp_f32 v67, v67
    v_exp_f32 v68, v68
    v_exp_f32 v69, v69
    v_add_f32 v120, v56, v57
    v_add_f32 v120, v120, v58
    v_add_f32 v120, v120, v59
    v_add_f32 v120, v120, v60
    v_add_f32 v120, v120, v61
    v_add_f32 v120, v120, v62
    v_add_f32 v120, v120, v63
    v_add_f32 v120, v120, v64
    v_add_f32 v120, v120, v65
    v_add_f32 v120, v120, v66
    v_add_f32 v120, v120, v67
    v_add_f32 v120, v120, v68
    v_add_f32 v120, v120, v69
    v_mov_b32 v121, v120
    s_nop 1
    v_permlane32_swap_b32 v120, v121
    s_nop 1
    v_add_f32 v120, v120, v121
    v_rcp_f32 v120, v120
    s_nop 0
    v_mul_f32 v56, v56, v120
    v_mul_f32 v57, v57, v120
    v_mul_f32 v58, v58, v120
    v_mul_f32 v59, v59, v120
    v_mul_f32 v60, v60, v120
    v_mul_f32 v61, v61, v120
    v_mul_f32 v62, v62, v120
    v_mul_f32 v63, v63, v120
    v_mul_f32 v64, v64, v120
    v_mul_f32 v65, v65, v120
    v_mul_f32 v66, v66, v120
    v_mul_f32 v67, v67, v120
    v_mul_f32 v68, v68, v120
    v_mul_f32 v69, v69, v120
    v_cvt_pk_bf16_f32 v88, v56, v57
    v_cvt_pk_bf16_f32 v89, v58, v59
    v_cvt_pk_bf16_f32 v90, v60, v61
    v_cvt_pk_bf16_f32 v91, v62, v63
    v_cvt_pk_bf16_f32 v92, v64, v65
    v_cvt_pk_bf16_f32 v93, v66, v67
    v_cvt_pk_bf16_f32 v94, v68, v69
    v_mov_b32 v95, 0
    ds_read_b64_tr_b16 v[52:53], v127 offset:12288
    ds_read_b64_tr_b16 v[54:55], v127 offset:13312
    s_waitcnt lgkmcnt(6)
    v_mfma_f32_32x32x16_bf16 v[56:71], v[8:11], v[40:43], 0
    ds_read_b64_tr_b16 v[40:41], v127 offset:16384
    ds_read_b64_tr_b16 v[42:43], v127 offset:17408
    s_waitcnt lgkmcnt(6)
    v_mfma_f32_32x32x16_bf16 v[56:71], v[12:15], v[44:47], v[56:71]
    ds_read_b64_tr_b16 v[44:45], v127 offset:20480
    ds_read_b64_tr_b16 v[46:47], v127 offset:21504
    s_waitcnt lgkmcnt(6)
    v_mfma_f32_32x32x16_bf16 v[56:71], v[16:19], v[48:51], v[56:71]
    ds_read_b64_tr_b16 v[48:49], v127 offset:24576
    ds_read_b64_tr_b16 v[50:51], v127 offset:25600
    s_waitcnt lgkmcnt(6)
    v_mfma_f32_32x32x16_bf16 v[56:71], v[20:23], v[52:55], v[56:71]
    ds_read_b64_tr_b16 v[52:53], v127 offset:28672
    ds_read_b64_tr_b16 v[54:55], v127 offset:29696
    s_waitcnt lgkmcnt(6)
    v_mfma_f32_32x32x16_bf16 v[56:71], v[24:27], v[40:43], v[56:71]
    v_xor_b32 v127, 192, v7
    ds_read_b64_tr_b16 v[40:41], v127 offset:0
    ds_read_b64_tr_b16 v[42:43], v127 offset:1024
    s_waitcnt lgkmcnt(6)
    v_mfma_f32_32x32x16_bf16 v[56:71], v[28:31], v[44:47], v[56:71]
    ds_read_b64_tr_b16 v[44:45], v127 offset:4096
    ds_read_b64_tr_b16 v[46:47], v127 offset:5120
    s_waitcnt lgkmcnt(6)
    v_mfma_f32_32x32x16_bf16 v[56:71], v[32:35], v[48:51], v[56:71]
    ds_read_b64_tr_b16 v[48:49], v127 offset:8192
    ds_read_b64_tr_b16 v[50:51], v127 offset:9216
    s_waitcnt lgkmcnt(6)
    v_mfma_f32_32x32x16_bf16 v[56:71], v[36:39], v[52:55], v[56:71]
    ds_read_b64_tr_b16 v[52:53], v127 offset:12288
    ds_read_b64_tr_b16 v[54:55], v127 offset:13312
    s_waitcnt lgkmcnt(6)
    v_mfma_f32_32x32x16_bf16 v[72:87], v[8:11], v[40:43], 0
    ds_read_b64_tr_b16 v[40:41], v127 offset:16384
    ds_read_b64_tr_b16 v[42:43], v127 offset:17408
    s_waitcnt lgkmcnt(6)
    v_mfma_f32_32x32x16_bf16 v[72:87], v[12:15], v[44:47], v[72:87]
    ds_read_b64_tr_b16 v[44:45], v127 offset:20480
    ds_read_b64_tr_b16 v[46:47], v127 offset:21504
    s_waitcnt lgkmcnt(6)
    v_mfma_f32_32x32x16_bf16 v[72:87], v[16:19], v[48:51], v[72:87]
    ds_read_b64_tr_b16 v[48:49], v127 offset:24576
    ds_read_b64_tr_b16 v[50:51], v127 offset:25600
    s_waitcnt lgkmcnt(6)
    v_mfma_f32_32x32x16_bf16 v[72:87], v[20:23], v[52:55], v[72:87]
    ds_read_b64_tr_b16 v[52:53], v127 offset:28672
    ds_read_b64_tr_b16 v[54:55], v127 offset:29696
    s_waitcnt lgkmcnt(6)
    v_mfma_f32_32x32x16_bf16 v[72:87], v[24:27], v[40:43], v[72:87]
    v_xor_b32 v127, 128, v7
    ds_read_b64_tr_b16 v[40:41], v127 offset:32768
    ds_read_b64_tr_b16 v[42:43], v127 offset:33792
    s_waitcnt lgkmcnt(6)
    v_mfma_f32_32x32x16_bf16 v[72:87], v[28:31], v[44:47], v[72:87]
    ds_read_b64_tr_b16 v[44:45], v127 offset:36864
    ds_read_b64_tr_b16 v[46:47], v127 offset:37888
    s_waitcnt lgkmcnt(6)
    v_mfma_f32_32x32x16_bf16 v[72:87], v[32:35], v[48:51], v[72:87]
    ds_read_b64_tr_b16 v[48:49], v127 offset:40960
    ds_read_b64_tr_b16 v[50:51], v127 offset:41984
    s_waitcnt lgkmcnt(6)
    v_mfma_f32_32x32x16_bf16 v[72:87], v[36:39], v[52:55], v[72:87]
    s_nop 7
    s_nop 4
    v_cvt_pk_bf16_f32 v104, v56, v57
    v_cvt_pk_bf16_f32 v105, v58, v59
    v_cvt_pk_bf16_f32 v106, v60, v61
    v_cvt_pk_bf16_f32 v107, v62, v63
    v_cvt_pk_bf16_f32 v108, v64, v65
    v_cvt_pk_bf16_f32 v109, v66, v67
    v_cvt_pk_bf16_f32 v110, v68, v69
    v_cvt_pk_bf16_f32 v111, v70, v71
    v_cvt_pk_bf16_f32 v112, v72, v73
    v_cvt_pk_bf16_f32 v113, v74, v75
    v_cvt_pk_bf16_f32 v114, v76, v77
    v_cvt_pk_bf16_f32 v115, v78, v79
    v_cvt_pk_bf16_f32 v116, v80, v81
    v_cvt_pk_bf16_f32 v117, v82, v83
    v_cvt_pk_bf16_f32 v118, v84, v85
    v_cvt_pk_bf16_f32 v119, v86, v87
    ds_read_b64_tr_b16 v[52:53], v127 offset:45056
    ds_read_b64_tr_b16 v[54:55], v127 offset:46080
    s_waitcnt lgkmcnt(6)
    v_mfma_f32_32x32x16_bf16 v[56:71], v[40:43], v[8:11], 0
    ds_read_b64_tr_b16 v[40:41], v127 offset:49152
    ds_read_b64_tr_b16 v[42:43], v127 offset:50176
    s_waitcnt lgkmcnt(6)
    v_mfma_f32_32x32x16_bf16 v[56:71], v[44:47], v[12:15], v[56:71]
    ds_read_b64_tr_b16 v[44:45], v127 offset:53248
    ds_read_b64_tr_b16 v[46:47], v127 offset:54272
    s_waitcnt lgkmcnt(6)
    v_mfma_f32_32x32x16_bf16 v[56:71], v[48:51], v[16:19], v[56:71]
    ds_read_b64_tr_b16 v[48:49], v127 offset:57344
    ds_read_b64_tr_b16 v[50:51], v127 offset:58368
    s_waitcnt lgkmcnt(6)
    v_mfma_f32_32x32x16_bf16 v[56:71], v[52:55], v[20:23], v[56:71]
    ds_read_b64_tr_b16 v[52:53], v127 offset:61440
    ds_read_b64_tr_b16 v[54:55], v127 offset:62464
    s_waitcnt lgkmcnt(6)
    v_mfma_f32_32x32x16_bf16 v[56:71], v[40:43], v[24:27], v[56:71]
    v_xor_b32 v127, 192, v7
    ds_read_b64_tr_b16 v[40:41], v127 offset:32768
    ds_read_b64_tr_b16 v[42:43], v127 offset:33792
    s_waitcnt lgkmcnt(6)
    v_mfma_f32_32x32x16_bf16 v[56:71], v[44:47], v[28:31], v[56:71]
    ds_read_b64_tr_b16 v[44:45], v127 offset:36864
    ds_read_b64_tr_b16 v[46:47], v127 offset:37888
    s_waitcnt lgkmcnt(6)
    v_mfma_f32_32x32x16_bf16 v[56:71], v[48:51], v[32:35], v[56:71]
    ds_read_b64_tr_b16 v[48:49], v127 offset:40960
    ds_read_b64_tr_b16 v[50:51], v127 offset:41984
    s_waitcnt lgkmcnt(6)
    v_mfma_f32_32x32x16_bf16 v[56:71], v[52:55], v[36:39], v[56:71]
    ds_read_b64_tr_b16 v[52:53], v127 offset:45056
    ds_read_b64_tr_b16 v[54:55], v127 offset:46080
    s_waitcnt lgkmcnt(6)
    v_mfma_f32_32x32x16_bf16 v[72:87], v[40:43], v[8:11], 0
    ds_read_b64_tr_b16 v[40:41], v127 offset:49152
    ds_read_b64_tr_b16 v[42:43], v127 offset:50176
    s_waitcnt lgkmcnt(6)
    v_mfma_f32_32x32x16_bf16 v[72:87], v[44:47], v[12:15], v[72:87]
    ds_read_b64_tr_b16 v[44:45], v127 offset:53248
    ds_read_b64_tr_b16 v[46:47], v127 offset:54272
    s_waitcnt lgkmcnt(6)
    v_mfma_f32_32x32x16_bf16 v[72:87], v[48:51], v[16:19], v[72:87]
    ds_read_b64_tr_b16 v[48:49], v127 offset:57344
    ds_read_b64_tr_b16 v[50:51], v127 offset:58368
    s_waitcnt lgkmcnt(6)
    v_mfma_f32_32x32x16_bf16 v[72:87], v[52:55], v[20:23], v[72:87]
    ds_read_b64_tr_b16 v[52:53], v127 offset:61440
    ds_read_b64_tr_b16 v[54:55], v127 offset:62464
    s_waitcnt lgkmcnt(6)
    v_mfma_f32_32x32x16_bf16 v[72:87], v[40:43], v[24:27], v[72:87]
    s_waitcnt lgkmcnt(4)
    v_mfma_f32_32x32x16_bf16 v[72:87], v[44:47], v[28:31], v[72:87]
    s_waitcnt lgkmcnt(2)
    v_mfma_f32_32x32x16_bf16 v[72:87], v[48:51], v[32:35], v[72:87]
    s_waitcnt lgkmcnt(0)
    v_mfma_f32_32x32x16_bf16 v[72:87], v[52:55], v[36:39], v[72:87]
    s_nop 1
    v_mfma_f32_32x32x16_bf16 v[56:71], v[104:107], v[88:91], v[56:71]
    v_mfma_f32_32x32x16_bf16 v[56:71], v[108:111], v[92:95], v[56:71]
    v_mfma_f32_32x32x16_bf16 v[72:87], v[112:115], v[88:91], v[72:87]
    v_mfma_f32_32x32x16_bf16 v[72:87], v[116:119], v[92:95], v[72:87]
    s_nop 7
    s_nop 4
    v_max_f32 v56, 0, v56
    v_max_f32 v57, 0, v57
    v_max_f32 v58, 0, v58
    v_max_f32 v59, 0, v59
    v_max_f32 v60, 0, v60
    v_max_f32 v61, 0, v61
    v_max_f32 v62, 0, v62
    v_max_f32 v63, 0, v63
    v_max_f32 v64, 0, v64
    v_max_f32 v65, 0, v65
    v_max_f32 v66, 0, v66
    v_max_f32 v67, 0, v67
    v_max_f32 v68, 0, v68
    v_max_f32 v69, 0, v69
    v_max_f32 v70, 0, v70
    v_max_f32 v71, 0, v71
    v_cvt_pk_bf16_f32 v104, v56, v57
    v_cvt_pk_bf16_f32 v105, v58, v59
    v_cvt_pk_bf16_f32 v106, v60, v61
    v_cvt_pk_bf16_f32 v107, v62, v63
    v_cvt_pk_bf16_f32 v108, v64, v65
    v_cvt_pk_bf16_f32 v109, v66, v67
    v_cvt_pk_bf16_f32 v110, v68, v69
    v_cvt_pk_bf16_f32 v111, v70, v71
    v_max_f32 v72, 0, v72
    v_max_f32 v73, 0, v73
    v_max_f32 v74, 0, v74
    v_max_f32 v75, 0, v75
    v_max_f32 v76, 0, v76
    v_max_f32 v77, 0, v77
    v_max_f32 v78, 0, v78
    v_max_f32 v79, 0, v79
    v_max_f32 v80, 0, v80
    v_max_f32 v81, 0, v81
    v_max_f32 v82, 0, v82
    v_max_f32 v83, 0, v83
    v_max_f32 v84, 0, v84
    v_max_f32 v85, 0, v85
    v_max_f32 v86, 0, v86
    v_max_f32 v87, 0, v87
    v_cvt_pk_bf16_f32 v112, v72, v73
    v_cvt_pk_bf16_f32 v113, v74, v75
    v_cvt_pk_bf16_f32 v114, v76, v77
    v_cvt_pk_bf16_f32 v115, v78, v79
    v_cvt_pk_bf16_f32 v116, v80, v81
    v_cvt_pk_bf16_f32 v117, v82, v83
    v_cvt_pk_bf16_f32 v118, v84, v85
    v_cvt_pk_bf16_f32 v119, v86, v87
    v_and_b32 v122, 7, v1
    v_lshlrev_b32 v123, 1, v4
    v_xor_b32 v122, v122, v123
    v_and_b32 v123, 15, v1
    v_lshlrev_b32 v123, 7, v123
    v_lshl_add_u32 v120, v122, 4, v123
    v_add_u32 v120, s49, v120
    v_lshrrev_b32 v122, 3, v1
    v_and_b32 v123, 7, v1
    v_xor_b32 v123, v123, v122
    v_lshlrev_b32 v123, 4, v123
    v_lshl_add_u32 v121, v122, 7, v123
    v_add_u32 v121, s49, v121
    v_xor_b32 v122, 0, v120
    v_xor_b32 v123, 16, v120
    v_xor_b32 v124, 64, v120
    v_xor_b32 v125, 80, v120
    s_mov_b64 exec, s[50:51]
    ds_write_b128 v122, v[104:107]
    ds_write_b128 v123, v[108:111]
    ds_write_b128 v124, v[112:115]
    ds_write_b128 v125, v[116:119]
    s_mov_b64 exec, -1
    s_waitcnt lgkmcnt(0)
    ds_read_b128 v[56:59], v121
    ds_read_b128 v[60:63], v121 offset:1024
    s_waitcnt lgkmcnt(0)
    buffer_store_dwordx4 v[56:59], v3, s[36:39], 0 offen offset:128 nt
    buffer_store_dwordx4 v[60:63], v3, s[36:39], 0 offen offset:2176 nt
    s_mov_b64 exec, s[52:53]
    ds_write_b128 v122, v[104:107]
    ds_write_b128 v123, v[108:111]
    ds_write_b128 v124, v[112:115]
    ds_write_b128 v125, v[116:119]
    s_mov_b64 exec, -1
    s_waitcnt lgkmcnt(0)
    ds_read_b128 v[64:67], v121
    ds_read_b128 v[68:71], v121 offset:1024
    s_waitcnt lgkmcnt(0)
    buffer_store_dwordx4 v[64:67], v3, s[36:39], s54 offen offset:128 nt
    s_mov_b64 exec, 0xffff
    buffer_store_dwordx4 v[68:71], v3, s[36:39], s54 offen offset:2176 nt
    s_mov_b64 exec, -1
L_done:
s_endpgm
.section .rodata,"a"
.p2align 6
.amdhsa_kernel standalone__attention_interact_autoint__recsys_kernel
  .amdhsa_next_free_vgpr 128
  .amdhsa_next_free_sgpr 96
  .amdhsa_accum_offset 128
  .amdhsa_group_segment_fixed_size 0
  .amdhsa_kernarg_size 64
  .amdhsa_user_sgpr_count 2
  .amdhsa_user_sgpr_kernarg_segment_ptr 1
  .amdhsa_system_sgpr_workgroup_id_x 1
.end_amdhsa_kernel
```
